```python
import torch

def _softmax(x, axis=-1):
    return torch.softmax(x, dim=axis)
def _gelu(x):
    return torch.nn.functional.gelu(x, approximate="tanh")
def _silu(x):
    return torch.nn.functional.silu(x)
def _sigmoid(x):
    return torch.sigmoid(x)
def _layernorm(x, axis=-1, eps=1e-5):
    m = x.mean(dim=axis, keepdim=True)
    v = x.var(dim=axis, keepdim=True, unbiased=False)
    return (x - m) / torch.sqrt(v + eps)
def _scatter_add(tgt, idx, src, axis=0):
    return tgt.clone().index_add_(axis, idx, src)
def _segment_sum(src, seg, n):
    out = torch.zeros((n,) + src.shape[1:], dtype=src.dtype)
    return out.index_add_(0, seg, src)
def _pad(x, pw):
    flat = tuple(v for pair in reversed(pw) for v in pair)
    return torch.nn.functional.pad(x, flat)

kernel_name = 'standalone__sliding_block_cached__decode'

def setup_inputs():

    _w = (lambda a: (lambda t: t.to(torch.bfloat16) if t.is_floating_point() else t)(torch.as_tensor(a)))
    B, Sq, D = 2, 1, 512
    Hq, Hkv, Sk, Dh = 32, 8, 32768, 128
    assert Hq % Hkv == 0, (Hq, Hkv)
    return {
        "x": _w((lambda *s: torch.randn(*s, dtype=torch.bfloat16) * 0.8)(B, Sq, D)),
        "k_cache": _w((lambda *s: torch.randn(*s, dtype=torch.bfloat16) * 0.8)(B, Hkv, Sk, Dh)),
        "v_cache": _w((lambda *s: torch.randn(*s, dtype=torch.bfloat16) * 0.05)(B, Hkv, Sk, Dh)),
        "wq": _w((lambda *s: torch.randn(*s, dtype=torch.bfloat16) * 0.8)(D, Hq * Dh) * (D ** -0.5)),
        "wo": _w((lambda *s: torch.randn(*s, dtype=torch.bfloat16) * 0.05)(Hq * Dh, D) * ((Hq * Dh) ** -0.5)),
    }

def reference(x, k_cache, v_cache, wq, wo):
    B, Sq, D = x.shape
    Hq, Dh = 32, 128
    Hkv, Sk = k_cache.shape[1], k_cache.shape[2]
    W = min(4096, max(256, Sk // 4))
    rep = Hq // Hkv
    q = (lambda x, *d: x.permute(*d))((x @ wq).reshape(B, Sq, Hq, Dh), 0, 2, 1, 3)
    k = (lambda x, n, axis: torch.repeat_interleave(x, n, dim=axis))(k_cache[:, :, Sk - W:, :], rep, axis=1)
    v = (lambda x, n, axis: torch.repeat_interleave(x, n, dim=axis))(v_cache[:, :, Sk - W:, :], rep, axis=1)
    scores = torch.einsum("bhqd,bhkd->bhqk", q, k) * (Dh ** -0.5)
    p = _softmax(scores, axis=-1)
    o = torch.einsum("bhqk,bhkd->bhqd", p, v)
    return (lambda x, *d: x.permute(*d))(o, 0, 2, 1, 3).reshape(B, Sq, Hq * Dh) @ wo
```

```asm
; @launch grid=(256,1,1) block=(576,1,1) lds=22528
.amdgcn_target "amdgcn-amd-amdhsa--gfx950"
.text
.globl standalone__sliding_block_cached__decode_kernel
.p2align 8
.type standalone__sliding_block_cached__decode_kernel,@function
standalone__sliding_block_cached__decode_kernel:
s_cmp_ge_u32 s2, 256
s_cbranch_scc1 L_end
s_load_dwordx16 s[4:19], s[0:1], 0
v_lshrrev_b32 v1, 6, v0
v_and_b32 v2, 63, v0
v_readfirstlane_b32 s3, v1
v_mov_b32 v15, 0
v_mov_b32 v13, 1
s_and_b32 s20, s2, 7
s_lshr_b32 s21, s2, 3
s_and_b32 s22, s21, 1
s_lshr_b32 s23, s21, 1
v_lshlrev_b32 v3, 4, v2
s_mov_b32 s42, 1114112
s_mov_b32 s43, 0x20000
s_mov_b32 s39, 0x20000
s_lshl_b32 s46, s20, 5
s_cmp_lg_u32 s3, 0
s_cbranch_scc1 L_kv0
s_setprio 3
v_lshlrev_b32 v4, 2, v2
ds_write_b32 v4, v15
s_and_b32 s26, s21, 7
s_lshr_b32 s27, s21, 3
v_and_b32 v6, 7, v2
v_lshlrev_b32 v4, 4, v6
v_lshrrev_b32 v5, 3, v2
v_lshl_add_u32 v4, v5, 16, v4
s_lshl_b32 s28, s27, 13
s_lshl3_add_u32 s29, s20, s26
s_add_u32 s28, s28, s29
s_lshl_b32 s28, s28, 7
v_bfe_u32 v5, v2, 2, 1
v_lshlrev_b32 v5, 10, v5
v_lshrrev_b32 v7, 4, v2
v_lshl_add_u32 v5, v7, 5, v5
v_and_b32 v8, 1, v2
v_lshl_add_u32 v5, v8, 4, v5
s_lshl_b32 s29, s27, 8
v_add_u32 v5, s29, v5
v_and_b32 v7, 1, v7
v_lshlrev_b32 v7, 8, v7
v_lshl_add_u32 v6, v6, 5, v7
v_and_b32 v7, 8, v2
v_lshl_add_u32 v6, v7, 1, v6
v_mov_b32 v84, -1
v_mov_b32 v85, -1
v_mov_b32 v86, -1
v_mov_b32 v87, -1
v_lshlrev_b32 v12, 3, v2
s_add_u32 s44, s46, s21
s_mul_i32 s44, s44, 4352
s_mov_b32 s38, 4194304
s_waitcnt lgkmcnt(0)
s_mov_b64 s[36:37], s[10:11]
s_mov_b64 s[40:41], s[18:19]
buffer_load_dwordx4 v[16:19], v4, s[36:39], s28 offen nt
s_addk_i32 s28, 8192
buffer_load_dwordx4 v[20:23], v4, s[36:39], s28 offen nt
s_addk_i32 s28, 8192
global_load_dwordx4 v[8:11], v5, s[4:5]
global_load_dwordx4 v[80:83], v5, s[4:5] offset:128
buffer_load_dwordx4 v[120:123], v6, s[40:43], s44 offen offset:0 sc1
buffer_load_dwordx4 v[24:27], v4, s[36:39], s28 offen nt
s_addk_i32 s28, 8192
buffer_load_dwordx4 v[28:31], v4, s[36:39], s28 offen nt
s_addk_i32 s28, 8192
buffer_load_dwordx4 v[32:35], v4, s[36:39], s28 offen nt
s_addk_i32 s28, 8192
buffer_load_dwordx4 v[36:39], v4, s[36:39], s28 offen nt
s_addk_i32 s28, 8192
buffer_load_dwordx4 v[40:43], v4, s[36:39], s28 offen nt
s_addk_i32 s28, 8192
buffer_load_dwordx4 v[44:47], v4, s[36:39], s28 offen nt
s_add_u32 s28, s28, 466944
buffer_load_dwordx4 v[48:51], v4, s[36:39], s28 offen nt
s_addk_i32 s28, 8192
buffer_load_dwordx4 v[52:55], v4, s[36:39], s28 offen nt
s_addk_i32 s28, 8192
buffer_load_dwordx4 v[56:59], v4, s[36:39], s28 offen nt
s_addk_i32 s28, 8192
buffer_load_dwordx4 v[60:63], v4, s[36:39], s28 offen nt
s_addk_i32 s28, 8192
buffer_load_dwordx4 v[64:67], v4, s[36:39], s28 offen nt
s_addk_i32 s28, 8192
buffer_load_dwordx4 v[68:71], v4, s[36:39], s28 offen nt
s_addk_i32 s28, 8192
buffer_load_dwordx4 v[72:75], v4, s[36:39], s28 offen nt
s_addk_i32 s28, 8192
buffer_load_dwordx4 v[76:79], v4, s[36:39], s28 offen nt
buffer_store_dwordx4 v[84:87], v3, s[40:43], s44 offen offset:512 sc1
buffer_store_dwordx4 v[84:87], v3, s[40:43], s44 offen offset:1536 sc1
buffer_store_dwordx4 v[84:87], v3, s[40:43], s44 offen offset:2560 sc1
buffer_store_dwordx2 v[84:85], v12, s[40:43], s44 offen offset:3584 sc1
s_branch L_q
L_kv0:
s_sub_u32 s26, s3, 1
s_and_b32 s26, s26, 3
s_and_b32 s27, s2, 15
s_lshl_b32 s27, s27, 7
s_add_u32 s27, s27, s23
s_addk_i32 s27, 112
s_lshl_b32 s27, s27, 6
s_add_u32 s27, s27, s26
s_lshl_b32 s27, s27, 10
s_mov_b32 s38, 134217728
s_add_u32 s28, s2, s23
s_and_b32 s28, s28, 15
s_lshl_b32 s29, s28, 12
s_cmp_gt_u32 s3, 4
s_cbranch_scc0 L_k0
v_add_u32 v4, s27, v3
s_setprio 1
s_getpc_b64 s[48:49]
L_pf:
v_lshlrev_b32 v5, 6, v2
s_lshl_b32 s28, s26, 12
v_add_u32 v5, s28, v5
v_min_u32 v5, L_end-L_pf, v5
s_max_u32 s28, s26, s21
s_cmp_gt_u32 s28, 1
s_cbranch_scc1 L_v1
global_load_dword v8, v5, s[48:49]
L_v1:
s_waitcnt lgkmcnt(0)
s_mov_b64 s[36:37], s[8:9]
s_branch L_ld
L_k0:
s_setprio 2
v_bfe_u32 v4, v2, 2, 2
v_lshl_add_u32 v4, v4, 8, s27
v_lshrrev_b32 v5, 4, v2
v_lshl_add_u32 v4, v5, 6, v4
v_and_b32 v5, 3, v2
v_lshl_add_u32 v4, v5, 4, v4
v_lshrrev_b32 v6, 5, v2
v_bfe_u32 v7, v2, 4, 1
v_lshl_add_u32 v6, v6, 3, v7
v_mul_u32_u24 v6, 4352, v6
v_and_b32 v7, 15, v2
v_lshl_add_u32 v6, v7, 4, v6
s_lshl1_add_u32 s47, s26, s46
s_mul_i32 s47, s47, 4352
s_lshl_b32 s48, s22, 8
s_add_u32 s47, s47, s48
s_add_u32 s48, s47, 69632
s_waitcnt lgkmcnt(0)
s_mov_b64 s[40:41], s[18:19]
s_mov_b64 s[36:37], s[6:7]
buffer_load_dwordx4 v[112:115], v6, s[40:43], s47 offen offset:0 sc1
buffer_load_dwordx4 v[116:119], v6, s[40:43], s48 offen offset:0 sc1
s_branch L_ld1
L_ld:
s_barrier
L_ld1:
s_barrier
buffer_load_dwordx4 v[16:19], v4, s[36:39], s29 offen nt
s_addk_i32 s29, 0x1000
s_bitset0_b32 s29, 16
buffer_load_dwordx4 v[20:23], v4, s[36:39], s29 offen nt
s_addk_i32 s29, 0x1000
s_bitset0_b32 s29, 16
buffer_load_dwordx4 v[24:27], v4, s[36:39], s29 offen nt
s_addk_i32 s29, 0x1000
s_bitset0_b32 s29, 16
buffer_load_dwordx4 v[28:31], v4, s[36:39], s29 offen nt
s_addk_i32 s29, 0x1000
s_bitset0_b32 s29, 16
buffer_load_dwordx4 v[32:35], v4, s[36:39], s29 offen nt
s_addk_i32 s29, 0x1000
s_bitset0_b32 s29, 16
buffer_load_dwordx4 v[36:39], v4, s[36:39], s29 offen nt
s_addk_i32 s29, 0x1000
s_bitset0_b32 s29, 16
s_cmp_gt_u32 s3, 4
s_cbranch_scc1 L_ld2
s_barrier
L_ld2:
buffer_load_dwordx4 v[40:43], v4, s[36:39], s29 offen nt
s_addk_i32 s29, 0x1000
s_bitset0_b32 s29, 16
buffer_load_dwordx4 v[44:47], v4, s[36:39], s29 offen nt
s_addk_i32 s29, 0x1000
s_bitset0_b32 s29, 16
buffer_load_dwordx4 v[48:51], v4, s[36:39], s29 offen nt
s_addk_i32 s29, 0x1000
s_bitset0_b32 s29, 16
buffer_load_dwordx4 v[52:55], v4, s[36:39], s29 offen nt
s_addk_i32 s29, 0x1000
s_bitset0_b32 s29, 16
buffer_load_dwordx4 v[56:59], v4, s[36:39], s29 offen nt
s_addk_i32 s29, 0x1000
s_bitset0_b32 s29, 16
buffer_load_dwordx4 v[60:63], v4, s[36:39], s29 offen nt
s_addk_i32 s29, 0x1000
s_bitset0_b32 s29, 16
buffer_load_dwordx4 v[64:67], v4, s[36:39], s29 offen nt
s_addk_i32 s29, 0x1000
s_bitset0_b32 s29, 16
buffer_load_dwordx4 v[68:71], v4, s[36:39], s29 offen nt
s_addk_i32 s29, 0x1000
s_bitset0_b32 s29, 16
buffer_load_dwordx4 v[72:75], v4, s[36:39], s29 offen nt
s_addk_i32 s29, 0x1000
s_bitset0_b32 s29, 16
buffer_load_dwordx4 v[76:79], v4, s[36:39], s29 offen nt
s_cmp_gt_u32 s3, 4
s_cbranch_scc1 L_v
s_branch L_k
L_q:
s_mov_b32 s24, 0x05040100
s_mov_b32 s25, 0x07060302
s_getreg_b32 s30, hwreg(HW_REG_XCC_ID, 0, 4)
s_lshl_b32 s30, s30, 1
v_mov_b32 v1, s30
s_waitcnt vmcnt(16)
s_barrier
v_perm_b32 v128, v20, v16, s24
v_perm_b32 v129, v28, v24, s24
v_perm_b32 v130, v20, v16, s25
v_perm_b32 v131, v28, v24, s25
v_perm_b32 v132, v21, v17, s24
v_perm_b32 v133, v29, v25, s24
v_perm_b32 v134, v21, v17, s25
v_perm_b32 v135, v29, v25, s25
v_perm_b32 v136, v22, v18, s24
v_perm_b32 v137, v30, v26, s24
v_perm_b32 v138, v22, v18, s25
v_perm_b32 v139, v30, v26, s25
v_perm_b32 v140, v23, v19, s24
v_perm_b32 v141, v31, v27, s24
v_perm_b32 v142, v23, v19, s25
v_perm_b32 v143, v31, v27, s25
v_mfma_f32_16x16x16_bf16 v[88:91], v[8:9], v[128:129], 0
v_mfma_f32_16x16x16_bf16 v[92:95], v[8:9], v[130:131], 0
v_mfma_f32_16x16x16_bf16 v[96:99], v[8:9], v[132:133], 0
v_mfma_f32_16x16x16_bf16 v[100:103], v[8:9], v[134:135], 0
v_mfma_f32_16x16x16_bf16 v[104:107], v[8:9], v[136:137], 0
v_mfma_f32_16x16x16_bf16 v[108:111], v[8:9], v[138:139], 0
v_mfma_f32_16x16x16_bf16 v[112:115], v[8:9], v[140:141], 0
v_mfma_f32_16x16x16_bf16 v[116:119], v[8:9], v[142:143], 0
s_waitcnt vmcnt(12)
v_bfi_b32 v120, 1, v120, v1
v_bfi_b32 v121, 1, v121, v1
v_bfi_b32 v122, 1, v122, v1
v_bfi_b32 v123, 1, v123, v1
v_xor_b32 v120, 1, v120
v_xor_b32 v121, 1, v121
v_xor_b32 v122, 1, v122
v_xor_b32 v123, 1, v123
v_perm_b32 v16, v36, v32, s24
v_perm_b32 v17, v44, v40, s24
v_perm_b32 v18, v36, v32, s25
v_perm_b32 v19, v44, v40, s25
v_perm_b32 v20, v37, v33, s24
v_perm_b32 v21, v45, v41, s24
v_perm_b32 v22, v37, v33, s25
v_perm_b32 v23, v45, v41, s25
v_perm_b32 v24, v38, v34, s24
v_perm_b32 v25, v46, v42, s24
v_perm_b32 v26, v38, v34, s25
v_perm_b32 v27, v46, v42, s25
v_perm_b32 v28, v39, v35, s24
v_perm_b32 v29, v47, v43, s24
v_perm_b32 v30, v39, v35, s25
v_perm_b32 v31, v47, v43, s25
v_mfma_f32_16x16x16_bf16 v[88:91], v[10:11], v[16:17], v[88:91]
v_mfma_f32_16x16x16_bf16 v[92:95], v[10:11], v[18:19], v[92:95]
v_mfma_f32_16x16x16_bf16 v[96:99], v[10:11], v[20:21], v[96:99]
v_mfma_f32_16x16x16_bf16 v[100:103], v[10:11], v[22:23], v[100:103]
v_mfma_f32_16x16x16_bf16 v[104:107], v[10:11], v[24:25], v[104:107]
v_mfma_f32_16x16x16_bf16 v[108:111], v[10:11], v[26:27], v[108:111]
v_mfma_f32_16x16x16_bf16 v[112:115], v[10:11], v[28:29], v[112:115]
v_mfma_f32_16x16x16_bf16 v[116:119], v[10:11], v[30:31], v[116:119]
s_waitcnt vmcnt(8)
v_perm_b32 v32, v52, v48, s24
v_perm_b32 v33, v60, v56, s24
v_perm_b32 v34, v52, v48, s25
v_perm_b32 v35, v60, v56, s25
v_perm_b32 v36, v53, v49, s24
v_perm_b32 v37, v61, v57, s24
v_perm_b32 v38, v53, v49, s25
v_perm_b32 v39, v61, v57, s25
v_perm_b32 v40, v54, v50, s24
v_perm_b32 v41, v62, v58, s24
v_perm_b32 v42, v54, v50, s25
v_perm_b32 v43, v62, v58, s25
v_perm_b32 v44, v55, v51, s24
v_perm_b32 v45, v63, v59, s24
v_perm_b32 v46, v55, v51, s25
v_perm_b32 v47, v63, v59, s25
v_mfma_f32_16x16x16_bf16 v[88:91], v[80:81], v[32:33], v[88:91]
v_mfma_f32_16x16x16_bf16 v[92:95], v[80:81], v[34:35], v[92:95]
v_mfma_f32_16x16x16_bf16 v[96:99], v[80:81], v[36:37], v[96:99]
v_mfma_f32_16x16x16_bf16 v[100:103], v[80:81], v[38:39], v[100:103]
v_mfma_f32_16x16x16_bf16 v[104:107], v[80:81], v[40:41], v[104:107]
v_mfma_f32_16x16x16_bf16 v[108:111], v[80:81], v[42:43], v[108:111]
v_mfma_f32_16x16x16_bf16 v[112:115], v[80:81], v[44:45], v[112:115]
v_mfma_f32_16x16x16_bf16 v[116:119], v[80:81], v[46:47], v[116:119]
s_waitcnt vmcnt(4)
v_perm_b32 v48, v68, v64, s24
v_perm_b32 v49, v76, v72, s24
v_perm_b32 v50, v68, v64, s25
v_perm_b32 v51, v76, v72, s25
v_perm_b32 v52, v69, v65, s24
v_perm_b32 v53, v77, v73, s24
v_perm_b32 v54, v69, v65, s25
v_perm_b32 v55, v77, v73, s25
v_perm_b32 v56, v70, v66, s24
v_perm_b32 v57, v78, v74, s24
v_perm_b32 v58, v70, v66, s25
v_perm_b32 v59, v78, v74, s25
v_perm_b32 v60, v71, v67, s24
v_perm_b32 v61, v79, v75, s24
v_perm_b32 v62, v71, v67, s25
v_perm_b32 v63, v79, v75, s25
v_mfma_f32_16x16x16_bf16 v[88:91], v[82:83], v[48:49], v[88:91]
v_mfma_f32_16x16x16_bf16 v[92:95], v[82:83], v[50:51], v[92:95]
v_mfma_f32_16x16x16_bf16 v[96:99], v[82:83], v[52:53], v[96:99]
v_mfma_f32_16x16x16_bf16 v[100:103], v[82:83], v[54:55], v[100:103]
v_mfma_f32_16x16x16_bf16 v[104:107], v[82:83], v[56:57], v[104:107]
v_mfma_f32_16x16x16_bf16 v[108:111], v[82:83], v[58:59], v[108:111]
v_mfma_f32_16x16x16_bf16 v[112:115], v[82:83], v[60:61], v[112:115]
v_mfma_f32_16x16x16_bf16 v[116:119], v[82:83], v[62:63], v[116:119]
s_waitcnt vmcnt(0)
v_add_f32_dpp v16, v89, v88 row_shl:8 row_mask:0xf bank_mask:0x3
v_add_f32_dpp v17, v93, v92 row_shl:8 row_mask:0xf bank_mask:0x3
v_add_f32_dpp v18, v97, v96 row_shl:8 row_mask:0xf bank_mask:0x3
v_add_f32_dpp v19, v101, v100 row_shl:8 row_mask:0xf bank_mask:0x3
v_add_f32_dpp v16, v104, v105 row_shr:8 row_mask:0xf bank_mask:0xc
v_add_f32_dpp v17, v108, v109 row_shr:8 row_mask:0xf bank_mask:0xc
v_add_f32_dpp v18, v112, v113 row_shr:8 row_mask:0xf bank_mask:0xc
v_add_f32_dpp v19, v116, v117 row_shr:8 row_mask:0xf bank_mask:0xc
v_bfi_b32 v16, 31, v120, v16
v_bfi_b32 v17, 31, v121, v17
v_bfi_b32 v18, 31, v122, v18
v_bfi_b32 v19, 31, v123, v19
s_mov_b32 exec_hi, 0
buffer_store_dwordx4 v[16:19], v6, s[40:43], s44 offen offset:0
s_barrier
s_waitcnt vmcnt(0)
ds_write_b32 v15, v13 offset:20
s_lshl_b32 s30, s20, 2
s_add_u32 s50, s16, s30
s_addc_u32 s51, s17, 0
s_mov_b32 s62, 0
s_mov_b32 s60, 28
L_qw_1:
ds_read_b32 v14, v15 offset:0
ds_read_b32 v9, v15 offset:36
s_waitcnt lgkmcnt(0)
v_readfirstlane_b32 s61, v14
v_readfirstlane_b32 s30, v9
s_cmp_lg_u32 s30, 0
s_cbranch_scc1 L_qwr_3
s_cmp_ge_u32 s61, 4
s_cbranch_scc1 L_qwd_2
s_sleep 4
s_sub_u32 s60, s60, 1
s_cbranch_scc0 L_qw_1
L_qwr_3:
buffer_store_dwordx4 v[16:19], v6, s[40:43], s44 offen offset:0 sc1
L_qwd_2:
s_mov_b64 exec, -1
s_waitcnt vmcnt(0)
s_mov_b32 s60, 1048576
L_lw_4:
ds_read_b32 v14, v15 offset:4
s_waitcnt lgkmcnt(0)
v_readfirstlane_b32 s61, v14
s_cmp_ge_u32 s61, 4
s_cbranch_scc1 L_lwd_5
s_sleep 4
s_cmp_gt_u32 s60, 1048552
s_cbranch_scc1 L_du_6
s_cmp_lg_u32 s62, 0
s_cbranch_scc1 L_du_6
s_mov_b32 s62, 1
s_atomic_add s62, s[50:51], 0
L_du_6:
s_sub_u32 s60, s60, 1
s_cbranch_scc0 L_lw_4
L_lwd_5:
s_cmp_lg_u32 s21, 0
s_cbranch_scc1 L_tok_7
s_mov_b64 exec, 1
global_store_dword v15, v13, s[50:51] offset:128 sc1
s_mov_b64 exec, -1
L_tok_7:
s_add_u32 s58, s46, s21
s_sub_u32 s58, s58, 128
s_cmp_lt_u32 s58, 64
s_cbranch_scc1 L_qfs_9
s_mov_b32 s60, 1048576
L_lw_10:
ds_read_b32 v14, v15 offset:28
s_waitcnt lgkmcnt(0)
v_readfirstlane_b32 s61, v14
s_cmp_ge_u32 s61, 1
s_cbranch_scc1 L_lwd_11
s_sleep 8
s_cmp_gt_u32 s60, 1048548
s_cbranch_scc1 L_du_12
s_cmp_lg_u32 s62, 0
s_cbranch_scc1 L_du_12
s_mov_b32 s62, 1
s_atomic_add s62, s[50:51], 0
L_du_12:
s_sub_u32 s60, s60, 1
s_cbranch_scc0 L_lw_10
L_lwd_11:
s_branch L_qend_8
L_qfs_9:
s_mov_b32 s60, 1048576
L_lw_13:
ds_read_b32 v14, v15 offset:12
s_waitcnt lgkmcnt(0)
v_readfirstlane_b32 s61, v14
s_cmp_ge_u32 s61, 4
s_cbranch_scc1 L_lwd_14
s_sleep 4
s_sub_u32 s60, s60, 1
s_cbranch_scc0 L_lw_13
L_lwd_14:
L_final:
v_lshrrev_b32 v5, 5, v2
v_bfe_u32 v6, v2, 2, 3
v_lshl_add_u32 v5, v5, 5, v6
v_mul_u32_u24 v5, 4352, v5
v_and_b32 v6, 3, v2
v_lshl_add_u32 v5, v6, 4, v5
s_lshr_b32 s47, s58, 4
s_mul_i32 s47, s47, 34816
s_and_b32 s48, s58, 15
s_lshl_b32 s49, s48, 6
s_add_u32 s47, s47, s49
s_add_u32 s55, s47, 278528
s_add_u32 s56, s47, 557056
s_add_u32 s57, s47, 835584
s_lshr_b32 s53, s58, 4
s_lshl_b32 s53, s53, 8
s_lshr_b32 s54, s48, 2
s_lshl_b32 s54, s54, 6
s_add_u32 s53, s53, s54
s_bfe_u32 s54, s48, 0x10001
s_lshl_b32 s54, s54, 10
s_add_u32 s53, s53, s54
s_and_b32 s54, s48, 1
s_lshl_b32 s54, s54, 3
s_add_u32 s53, s53, s54
v_lshlrev_b32 v6, 1, v6
v_and_b32 v4, 48, v2
v_add_u32 v4, v4, v6
s_mov_b64 s[36:37], s[14:15]
s_movk_i32 s38, 2048
s_mov_b32 s60, 1048576
L_lw_15:
ds_read_b32 v14, v15 offset:28
s_waitcnt lgkmcnt(0)
v_readfirstlane_b32 s61, v14
s_cmp_ge_u32 s61, 1
s_cbranch_scc1 L_lwd_16
s_sleep 1
s_cmp_gt_u32 s60, 1048496
s_cbranch_scc1 L_du_17
s_cmp_lg_u32 s62, 0
s_cbranch_scc1 L_du_17
s_mov_b32 s62, 1
s_atomic_add s62, s[50:51], 0
L_du_17:
s_sub_u32 s60, s60, 1
s_cbranch_scc0 L_lw_15
L_lwd_16:
s_mov_b32 s60, 65536
v_lshlrev_b32 v9, 2, v2
s_mov_b64 exec, 0xff
L_pa_18:
global_load_dword v7, v9, s[16:17] offset:128 sc1
s_waitcnt vmcnt(0)
v_cmp_eq_u32 vcc, 0, v7
s_cbranch_vccz L_pad_19
s_sleep 16
s_cmp_gt_u32 s60, 65524
s_cbranch_scc1 L_du_20
s_cmp_lg_u32 s62, 0
s_cbranch_scc1 L_du_20
s_mov_b32 s62, 1
s_atomic_add s62, s[50:51], 0
L_du_20:
s_sub_u32 s60, s60, 1
s_cbranch_scc0 L_pa_18
L_pad_19:
s_mov_b64 exec, -1
s_mov_b32 s60, 65536
L_pe_21:
buffer_load_dwordx4 v[16:19], v5, s[40:43], s47 offen offset:512 sc1
buffer_load_dwordx4 v[20:23], v5, s[40:43], s55 offen offset:512 sc1
buffer_load_dwordx4 v[24:27], v5, s[40:43], s56 offen offset:512 sc1
buffer_load_dwordx4 v[28:31], v5, s[40:43], s57 offen offset:512 sc1
L_pec_23:
s_waitcnt vmcnt(0)
v_max3_u32 v7, v16, v17, v18
v_max3_u32 v7, v7, v19, v20
v_max3_u32 v7, v7, v21, v22
v_max3_u32 v7, v7, v23, v24
v_max3_u32 v7, v7, v25, v26
v_max3_u32 v7, v7, v27, v28
v_max3_u32 v7, v7, v29, v30
v_max_u32 v7, v7, v31
v_cmp_eq_u32 vcc, -1, v7
s_mov_b64 exec, vcc
s_cbranch_execz L_ped_22
s_sub_u32 s60, s60, 1
s_cbranch_scc0 L_pe_21
L_ped_22:
s_mov_b64 exec, -1
v_add_f32 v16, v16, v20
v_add_f32 v17, v17, v21
v_add_f32 v18, v18, v22
v_add_f32 v19, v19, v23
v_add_f32 v24, v24, v28
v_add_f32 v25, v25, v29
v_add_f32 v26, v26, v30
v_add_f32 v27, v27, v31
v_add_f32 v16, v16, v24
v_add_f32 v18, v18, v26
v_add_f32 v17, v17, v25
v_add_f32 v19, v19, v27
v_permlane32_swap_b32 v16, v18
s_nop 0
v_permlane32_swap_b32 v17, v19
v_add_f32 v16, v16, v18
v_add_f32 v17, v17, v19
s_nop 1
v_permlane16_swap_b32 v16, v17
s_nop 0
v_add_f32 v16, v16, v17
s_nop 1
v_add_f32_dpp v16, v16, v16 row_ror:4 row_mask:0xf bank_mask:0xf
s_nop 1
v_add_f32_dpp v16, v16, v16 row_ror:8 row_mask:0xf bank_mask:0xf
s_mov_b32 exec_lo, 0x000f000f
s_mov_b32 exec_hi, 0x000f000f
v_cvt_pk_bf16_f32 v16, v16, v16
buffer_store_short v16, v4, s[36:39], s53 offen
L_qend_8:
s_endpgm
L_v:
s_and_b32 s27, s21, 7
s_lshr_b32 s28, s21, 3
v_lshrrev_b32 v7, 4, v2
v_lshlrev_b32 v9, 13, v7
v_and_b32 v5, 15, v2
v_lshl_add_u32 v9, v5, 4, v9
s_lshl_b32 s31, s20, 19
s_lshl_b32 s30, s26, 15
s_add_u32 s31, s31, s30
s_lshl_b32 s30, s27, 10
s_add_u32 s31, s31, s30
s_lshl_b32 s30, s28, 8
s_add_u32 s31, s31, s30
s_mov_b64 s[32:33], s[12:13]
s_mov_b32 s34, 4194304
s_mov_b32 s35, 0x20000
s_mov_b64 s[40:41], s[18:19]
buffer_load_dwordx4 v[120:123], v9, s[32:35], s31 offen nt
s_add_u32 s31, s31, 131072
buffer_load_dwordx4 v[124:127], v9, s[32:35], s31 offen nt
s_add_u32 s31, s31, 131072
buffer_load_dwordx4 v[128:131], v9, s[32:35], s31 offen nt
s_add_u32 s31, s31, 131072
buffer_load_dwordx4 v[132:135], v9, s[32:35], s31 offen nt
s_mov_b32 s24, 0x05040100
s_mov_b32 s25, 0x07060302
v_lshrrev_b32 v12, 2, v2
v_mul_u32_u24 v12, 4352, v12
v_and_b32 v9, 3, v2
v_lshl_add_u32 v6, v9, 4, v12
v_lshl_add_u32 v12, v9, 2, v12
s_mul_i32 s44, s46, 4352
s_lshl2_add_u32 s30, s27, s26
s_mul_i32 s30, s30, 80
s_add_u32 s44, s44, s30
s_add_u32 s44, s44, 1536
s_add_u32 s47, s44, 69632
s_add_u32 s45, s46, s21
s_mul_i32 s45, s45, 4352
v_lshlrev_b32 v4, 8, v7
v_bfe_u32 v5, v2, 2, 1
v_lshl_add_u32 v4, v5, 7, v4
v_bfe_u32 v5, v2, 3, 1
v_lshl_add_u32 v9, v5, 2, v9
v_lshl_add_u32 v4, v9, 4, v4
s_lshl_b32 s30, s26, 10
v_add_u32 v4, s30, v4
v_cmp_eq_u32 vcc, 0, v9
s_nop 1
v_cndmask_b32_e64 v136, 0, -1, vcc
v_cmp_eq_u32 vcc, 1, v9
s_nop 1
v_cndmask_b32_e64 v137, 0, -1, vcc
v_cmp_eq_u32 vcc, 2, v9
s_nop 1
v_cndmask_b32_e64 v138, 0, -1, vcc
v_cmp_eq_u32 vcc, 3, v9
s_nop 1
v_cndmask_b32_e64 v139, 0, -1, vcc
v_cmp_eq_u32 vcc, 4, v9
s_nop 1
v_cndmask_b32_e64 v140, 0, -1, vcc
v_cmp_eq_u32 vcc, 5, v9
s_nop 1
v_cndmask_b32_e64 v141, 0, -1, vcc
v_cmp_eq_u32 vcc, 6, v9
s_nop 1
v_cndmask_b32_e64 v142, 0, -1, vcc
v_cmp_eq_u32 vcc, 7, v9
s_nop 1
v_cndmask_b32_e64 v143, 0, -1, vcc
s_lshl_b32 s28, s26, 11
v_bfe_u32 v9, v2, 2, 2
v_lshl_add_u32 v116, v9, 2, v7
v_lshlrev_b32 v116, 6, v116
v_and_b32 v5, 3, v2
v_lshl_add_u32 v116, v5, 4, v116
v_add_u32 v116, s28, v116
v_and_b32 v5, 0x33, v2
v_lshl_add_u32 v5, v5, 4, s28
v_add_u32 v5, 2048, v5
v_mov_b32 v7, 240
v_add_u32 v1, 1024, v5
v_cmp_eq_u32 vcc, 0, v9
s_nop 1
v_cndmask_b32 v144, v7, v5, vcc
v_cndmask_b32 v148, v7, v1, vcc
v_cmp_eq_u32 vcc, 1, v9
s_nop 1
v_cndmask_b32 v145, v7, v5, vcc
v_cndmask_b32 v149, v7, v1, vcc
v_cmp_eq_u32 vcc, 2, v9
s_nop 1
v_cndmask_b32 v146, v7, v5, vcc
v_cndmask_b32 v150, v7, v1, vcc
v_cmp_eq_u32 vcc, 3, v9
s_nop 1
v_cndmask_b32 v147, v7, v5, vcc
v_cndmask_b32 v151, v7, v1, vcc
s_lshl_b32 s28, s26, 2
v_mov_b32 v1, s28
s_waitcnt vmcnt(18)
v_perm_b32 v80, v20, v16, s24
v_perm_b32 v84, v20, v16, s25
v_perm_b32 v88, v21, v17, s24
v_perm_b32 v92, v21, v17, s25
v_perm_b32 v96, v22, v18, s24
v_perm_b32 v100, v22, v18, s25
v_perm_b32 v104, v23, v19, s24
v_perm_b32 v108, v23, v19, s25
s_waitcnt vmcnt(16)
v_perm_b32 v81, v28, v24, s24
v_perm_b32 v85, v28, v24, s25
v_perm_b32 v89, v29, v25, s24
v_perm_b32 v93, v29, v25, s25
v_perm_b32 v97, v30, v26, s24
v_perm_b32 v101, v30, v26, s25
v_perm_b32 v105, v31, v27, s24
v_perm_b32 v109, v31, v27, s25
s_waitcnt vmcnt(14)
v_perm_b32 v82, v36, v32, s24
v_perm_b32 v86, v36, v32, s25
v_perm_b32 v90, v37, v33, s24
v_perm_b32 v94, v37, v33, s25
v_perm_b32 v98, v38, v34, s24
v_perm_b32 v102, v38, v34, s25
v_perm_b32 v106, v39, v35, s24
v_perm_b32 v110, v39, v35, s25
s_waitcnt vmcnt(12)
v_perm_b32 v83, v44, v40, s24
v_perm_b32 v87, v44, v40, s25
v_perm_b32 v91, v45, v41, s24
v_perm_b32 v95, v45, v41, s25
v_perm_b32 v99, v46, v42, s24
v_perm_b32 v103, v46, v42, s25
v_perm_b32 v107, v47, v43, s24
v_perm_b32 v111, v47, v43, s25
s_mov_b32 s60, 1048576
L_lw_24:
ds_read_b32 v14, v1 offset:64
s_waitcnt lgkmcnt(0)
v_readfirstlane_b32 s61, v14
s_cmp_ge_u32 s61, 1
s_cbranch_scc1 L_lwd_25
s_sleep 2
s_sub_u32 s60, s60, 1
s_cbranch_scc0 L_lw_24
L_lwd_25:
ds_read_b128 v[16:19], v144
ds_read_b128 v[20:23], v145
ds_read_b128 v[24:27], v146
ds_read_b128 v[28:31], v147
ds_read_b128 v[32:35], v148
ds_read_b128 v[36:39], v149
ds_read_b128 v[40:43], v150
ds_read_b128 v[44:47], v151
s_waitcnt lgkmcnt(0)
v_mfma_f32_16x16x32_bf16 v[8:11], v[80:83], v[16:19], 0
v_mfma_f32_16x16x32_bf16 v[8:11], v[84:87], v[20:23], v[8:11]
v_mfma_f32_16x16x32_bf16 v[8:11], v[88:91], v[24:27], v[8:11]
v_mfma_f32_16x16x32_bf16 v[8:11], v[92:95], v[28:31], v[8:11]
v_mfma_f32_16x16x32_bf16 v[112:115], v[96:99], v[16:19], 0
v_mfma_f32_16x16x32_bf16 v[112:115], v[100:103], v[20:23], v[112:115]
v_mfma_f32_16x16x32_bf16 v[112:115], v[104:107], v[24:27], v[112:115]
v_mfma_f32_16x16x32_bf16 v[112:115], v[108:111], v[28:31], v[112:115]
s_setprio 3
s_waitcnt vmcnt(10)
buffer_load_dword v162, v12, s[40:43], s44 offen offset:64 sc1
buffer_load_dword v163, v12, s[40:43], s47 offen offset:64 sc1
v_perm_b32 v80, v52, v48, s24
v_perm_b32 v84, v52, v48, s25
v_perm_b32 v88, v53, v49, s24
v_perm_b32 v92, v53, v49, s25
v_perm_b32 v96, v54, v50, s24
v_perm_b32 v100, v54, v50, s25
v_perm_b32 v104, v55, v51, s24
v_perm_b32 v108, v55, v51, s25
s_waitcnt vmcnt(10)
v_perm_b32 v81, v60, v56, s24
v_perm_b32 v85, v60, v56, s25
v_perm_b32 v89, v61, v57, s24
v_perm_b32 v93, v61, v57, s25
v_perm_b32 v97, v62, v58, s24
v_perm_b32 v101, v62, v58, s25
v_perm_b32 v105, v63, v59, s24
v_perm_b32 v109, v63, v59, s25
s_waitcnt vmcnt(8)
v_perm_b32 v82, v68, v64, s24
v_perm_b32 v86, v68, v64, s25
v_perm_b32 v90, v69, v65, s24
v_perm_b32 v94, v69, v65, s25
v_perm_b32 v98, v70, v66, s24
v_perm_b32 v102, v70, v66, s25
v_perm_b32 v106, v71, v67, s24
v_perm_b32 v110, v71, v67, s25
s_waitcnt vmcnt(6)
v_perm_b32 v83, v76, v72, s24
v_perm_b32 v87, v76, v72, s25
v_perm_b32 v91, v77, v73, s24
v_mfma_f32_16x16x32_bf16 v[8:11], v[80:83], v[32:35], v[8:11]
v_perm_b32 v95, v77, v73, s25
v_mfma_f32_16x16x32_bf16 v[8:11], v[84:87], v[36:39], v[8:11]
v_perm_b32 v99, v78, v74, s24
v_mfma_f32_16x16x32_bf16 v[8:11], v[88:91], v[40:43], v[8:11]
v_perm_b32 v103, v78, v74, s25
v_mfma_f32_16x16x32_bf16 v[8:11], v[92:95], v[44:47], v[8:11]
v_perm_b32 v107, v79, v75, s24
v_mfma_f32_16x16x32_bf16 v[112:115], v[96:99], v[32:35], v[112:115]
v_perm_b32 v111, v79, v75, s25
v_mfma_f32_16x16x32_bf16 v[112:115], v[100:103], v[36:39], v[112:115]
v_mfma_f32_16x16x32_bf16 v[112:115], v[104:107], v[40:43], v[112:115]
v_mfma_f32_16x16x32_bf16 v[112:115], v[108:111], v[44:47], v[112:115]
s_nop 1
ds_write_b128 v116, v[8:11] offset:10240
s_nop 4
ds_write_b128 v116, v[112:115] offset:11264
s_mov_b64 exec, 1
ds_add_u32 v15, v13 offset:12
s_mov_b64 exec, -1
s_setprio 1
s_waitcnt vmcnt(2)
v_perm_b32 v64, v124, v120, s24
v_perm_b32 v65, v132, v128, s24
v_perm_b32 v66, v124, v120, s25
v_perm_b32 v67, v132, v128, s25
v_perm_b32 v68, v125, v121, s24
v_perm_b32 v69, v133, v129, s24
v_perm_b32 v70, v125, v121, s25
v_perm_b32 v71, v133, v129, s25
v_perm_b32 v72, v126, v122, s24
v_perm_b32 v73, v134, v130, s24
v_perm_b32 v74, v126, v122, s25
v_perm_b32 v75, v134, v130, s25
v_perm_b32 v76, v127, v123, s24
v_perm_b32 v77, v135, v131, s24
v_perm_b32 v78, v127, v123, s25
v_perm_b32 v79, v135, v131, s25
s_mov_b32 s60, 65536
s_branch L_pec_28
L_pe_26:
buffer_load_dword v162, v12, s[40:43], s44 offen offset:64 sc1
buffer_load_dword v163, v12, s[40:43], s47 offen offset:64 sc1
L_pec_28:
s_waitcnt vmcnt(0)
v_max_u32 v7, v162, v163
v_cmp_eq_u32 vcc, -1, v7
s_mov_b64 exec, vcc
s_cbranch_execz L_ped_27
s_sleep 2
s_sub_u32 s60, s60, 1
s_cbranch_scc0 L_pe_26
L_ped_27:
s_mov_b64 exec, -1
v_max_f32 v16, v162, v163
s_nop 1
v_max_f32_dpp v16, v16, v16 row_ror:8 row_mask:0xf bank_mask:0xf
v_mov_b32 v17, v16
s_nop 1
v_permlane16_swap_b32 v16, v17
s_nop 0
v_max_f32 v16, v16, v17
v_mov_b32 v17, v16
s_nop 1
v_permlane32_swap_b32 v16, v17
s_nop 0
v_max_f32 v16, v16, v17
v_sub_f32 v162, v162, v16
v_sub_f32 v163, v163, v16
v_exp_f32 v162, v162
v_exp_f32 v163, v163
s_nop 0
v_add_f32 v16, v162, v163
s_nop 1
v_add_f32_dpp v16, v16, v16 row_ror:8 row_mask:0xf bank_mask:0xf
v_mov_b32 v17, v16
s_nop 1
v_permlane16_swap_b32 v16, v17
s_nop 0
v_add_f32 v16, v16, v17
v_mov_b32 v17, v16
s_nop 1
v_permlane32_swap_b32 v16, v17
s_nop 0
v_add_f32 v16, v16, v17
v_rcp_f32 v16, v16
s_nop 0
v_mul_f32 v162, v162, v16
v_mul_f32 v163, v163, v16
s_mov_b32 s60, 65536
L_pe_29:
buffer_load_dwordx4 v[154:157], v6, s[40:43], s44 offen sc1
buffer_load_dwordx4 v[158:161], v6, s[40:43], s47 offen sc1
L_pec_31:
s_waitcnt vmcnt(0)
v_max3_u32 v7, v154, v155, v156
v_max3_u32 v7, v7, v157, v158
v_max3_u32 v7, v7, v159, v160
v_max_u32 v7, v7, v161
v_cmp_eq_u32 vcc, -1, v7
s_mov_b64 exec, vcc
s_cbranch_execz L_ped_30
s_sub_u32 s60, s60, 1
s_cbranch_scc0 L_pe_29
L_ped_30:
s_mov_b64 exec, -1
v_mul_f32 v154, v154, v162
v_mul_f32 v155, v155, v162
v_mul_f32 v156, v156, v162
v_mul_f32 v157, v157, v162
v_fmac_f32 v154, v158, v163
v_fmac_f32 v156, v160, v163
v_fmac_f32 v155, v159, v163
v_fmac_f32 v157, v161, v163
v_permlane32_swap_b32 v154, v156
s_nop 0
v_permlane32_swap_b32 v155, v157
v_add_f32 v154, v154, v156
v_add_f32 v155, v155, v157
s_nop 1
v_permlane16_swap_b32 v154, v155
s_nop 0
v_add_f32 v154, v154, v155
s_nop 1
v_add_f32_dpp v154, v154, v154 row_ror:8 row_mask:0xf bank_mask:0xf
s_nop 1
v_mov_b32_dpp v158, v154 quad_perm:[0,0,0,0] row_mask:0xf bank_mask:0xf
v_mov_b32_dpp v159, v154 quad_perm:[1,1,1,1] row_mask:0xf bank_mask:0xf
v_mov_b32_dpp v160, v154 quad_perm:[2,2,2,2] row_mask:0xf bank_mask:0xf
v_mov_b32_dpp v161, v154 quad_perm:[3,3,3,3] row_mask:0xf bank_mask:0xf
v_cvt_pk_bf16_f32 v56, v158, v159
v_cvt_pk_bf16_f32 v57, v160, v161
v_and_b32 v80, v56, v136
v_and_b32 v81, v57, v136
v_and_b32 v82, v56, v137
v_and_b32 v83, v57, v137
v_mfma_f32_16x16x16_bf16 v[96:99], v[64:65], v[80:81], 0
v_and_b32 v84, v56, v138
v_and_b32 v85, v57, v138
v_mfma_f32_16x16x16_bf16 v[96:99], v[66:67], v[82:83], v[96:99]
v_and_b32 v86, v56, v139
v_and_b32 v87, v57, v139
v_mfma_f32_16x16x16_bf16 v[96:99], v[68:69], v[84:85], v[96:99]
v_and_b32 v88, v56, v140
v_and_b32 v89, v57, v140
v_mfma_f32_16x16x16_bf16 v[96:99], v[70:71], v[86:87], v[96:99]
v_and_b32 v90, v56, v141
v_and_b32 v91, v57, v141
v_mfma_f32_16x16x16_bf16 v[96:99], v[72:73], v[88:89], v[96:99]
v_and_b32 v92, v56, v142
v_and_b32 v93, v57, v142
v_mfma_f32_16x16x16_bf16 v[96:99], v[74:75], v[90:91], v[96:99]
v_and_b32 v94, v56, v143
v_and_b32 v95, v57, v143
v_mfma_f32_16x16x16_bf16 v[96:99], v[76:77], v[92:93], v[96:99]
s_nop 0
v_mfma_f32_16x16x16_bf16 v[96:99], v[78:79], v[94:95], v[96:99]
s_nop 7
ds_write_b128 v4, v[96:99] offset:18432
s_mov_b64 exec, 1
ds_add_rtn_u32 v6, v15, v13 offset:16
s_mov_b64 exec, -1
ds_read_b128 v[16:19], v3 offset:18432
ds_read_b128 v[20:23], v3 offset:19456
ds_read_b128 v[24:27], v3 offset:20480
ds_read_b128 v[28:31], v3 offset:21504
s_waitcnt lgkmcnt(2)
v_readfirstlane_b32 s28, v6
v_add_f32 v16, v16, v20
v_add_f32 v17, v17, v21
v_add_f32 v18, v18, v22
v_add_f32 v19, v19, v23
s_cmp_lg_u32 s28, 3
s_cbranch_scc1 L_s2end_32
s_waitcnt lgkmcnt(0)
v_add_f32 v24, v24, v28
v_add_f32 v25, v25, v29
v_add_f32 v26, v26, v30
v_add_f32 v27, v27, v31
v_add_f32 v16, v16, v24
v_add_f32 v17, v17, v25
v_add_f32 v18, v18, v26
v_add_f32 v19, v19, v27
buffer_store_dwordx4 v[16:19], v3, s[40:43], s45 offen offset:512 sc1
ds_write_b32 v15, v13 offset:28
L_s2end_32:
s_endpgm
L_k:
s_mov_b32 s31, 0xff000000
s_movk_i32 s32, 0xffe0
s_getreg_b32 s33, hwreg(HW_REG_XCC_ID, 0, 4)
s_lshl_b32 s33, s33, 1
s_lshl_b32 s30, s26, 8
v_and_b32 v7, 31, v2
v_lshl_add_u32 v7, v7, 3, s30
v_lshrrev_b32 v109, 2, v2
v_lshlrev_b32 v109, 4, v109
v_lshl_add_u32 v109, v5, 8, v109
s_mov_b32 s28, 0x3db504f3
s_mov_b32 s29, 0x3fb8aa3b
v_bfe_u32 v4, v2, 3, 1
v_lshlrev_b32 v4, 10, v4
v_and_b32 v9, 0x33, v2
v_lshl_add_u32 v4, v9, 4, v4
v_bfe_u32 v9, v2, 2, 1
v_lshl_add_u32 v4, v9, 3, v4
s_lshl_b32 s30, s26, 11
v_add_u32 v4, s30, v4
s_lshl_b32 s30, s26, 2
v_mov_b32 v1, s30
s_waitcnt vmcnt(16)
v_alignbit_b32 v12, v112, 0, 1
v_alignbit_b32 v12, v113, v12, 1
v_alignbit_b32 v12, v114, v12, 1
v_alignbit_b32 v12, v115, v12, 1
v_alignbit_b32 v12, v116, v12, 1
v_alignbit_b32 v12, v117, v12, 1
v_alignbit_b32 v12, v118, v12, 1
v_alignbit_b32 v12, v119, v12, 1
s_mov_b32 s60, 1048576
L_lw_33:
ds_read_b32 v14, v15 offset:20
s_waitcnt lgkmcnt(0)
v_readfirstlane_b32 s61, v14
s_cmp_ge_u32 s61, 1
s_cbranch_scc1 L_lwd_34
s_sleep 1
s_sub_u32 s60, s60, 1
s_cbranch_scc0 L_lw_33
L_lwd_34:
s_mov_b32 s60, 65536
s_mov_b32 s50, 0
buffer_load_dwordx4 v[112:115], v6, s[40:43], s47 offen offset:0 sc1
buffer_load_dwordx4 v[116:119], v6, s[40:43], s48 offen offset:0 sc1
s_waitcnt vmcnt(0)
v_alignbit_b32 v11, v112, 0, 1
v_alignbit_b32 v11, v113, v11, 1
v_alignbit_b32 v11, v114, v11, 1
v_alignbit_b32 v11, v115, v11, 1
v_alignbit_b32 v11, v116, v11, 1
v_alignbit_b32 v11, v117, v11, 1
v_alignbit_b32 v11, v118, v11, 1
v_alignbit_b32 v11, v119, v11, 1
v_xor_b32 v9, s33, v112
v_xor_b32 v10, s33, v116
v_or_b32 v9, v9, v10
v_and_b32 v9, 30, v9
v_and_b32 v80, s32, v112
v_and_b32 v81, s32, v113
v_and_b32 v82, s32, v114
v_and_b32 v83, s32, v115
v_and_b32 v84, s32, v116
v_and_b32 v85, s32, v117
v_and_b32 v86, s32, v118
v_and_b32 v87, s32, v119
v_xor_b32 v11, v11, v12
v_cmp_ne_u32 vcc, s31, v11
s_cbranch_vccz L_qok_35
L_sq_36:
s_cmp_gt_u32 s60, 65524
s_cbranch_scc1 L_sqs_37
s_sleep 40
s_lshl_b32 s30, s20, 2
s_add_u32 s52, s16, s30
s_addc_u32 s53, s17, 0
s_load_dword s50, s[52:53], 0 glc
s_waitcnt lgkmcnt(0)
L_sqs_37:
buffer_load_dwordx4 v[112:115], v6, s[40:43], s47 offen offset:0 sc1
buffer_load_dwordx4 v[116:119], v6, s[40:43], s48 offen offset:0 sc1
s_waitcnt vmcnt(0)
v_alignbit_b32 v11, v112, 0, 1
v_alignbit_b32 v11, v113, v11, 1
v_alignbit_b32 v11, v114, v11, 1
v_alignbit_b32 v11, v115, v11, 1
v_alignbit_b32 v11, v116, v11, 1
v_alignbit_b32 v11, v117, v11, 1
v_alignbit_b32 v11, v118, v11, 1
v_alignbit_b32 v11, v119, v11, 1
v_xor_b32 v9, s33, v112
v_xor_b32 v10, s33, v116
v_or_b32 v9, v9, v10
v_and_b32 v9, 30, v9
v_and_b32 v80, s32, v112
v_and_b32 v81, s32, v113
v_and_b32 v82, s32, v114
v_and_b32 v83, s32, v115
v_and_b32 v84, s32, v116
v_and_b32 v85, s32, v117
v_and_b32 v86, s32, v118
v_and_b32 v87, s32, v119
v_xor_b32 v11, v11, v12
v_cmp_ne_u32 vcc, s31, v11
s_cbranch_vccz L_qok_35
s_cmp_ge_u32 s50, 32
s_cbranch_scc1 L_qok_35
s_sleep 8
s_sub_u32 s60, s60, 1
s_cbranch_scc0 L_sq_36
L_qok_35:
v_add_f32 v80, v80, v84
v_add_f32 v81, v81, v85
v_add_f32 v82, v82, v86
v_add_f32 v83, v83, v87
v_mov_b32 v84, v80
v_mov_b32 v85, v81
v_mov_b32 v86, v82
v_mov_b32 v87, v83
v_permlane32_swap_b32 v80, v84
v_permlane32_swap_b32 v81, v85
v_permlane32_swap_b32 v82, v86
v_permlane32_swap_b32 v83, v87
v_add_f32 v80, v80, v84
v_add_f32 v81, v81, v85
v_add_f32 v82, v82, v86
v_add_f32 v83, v83, v87
v_cvt_pk_bf16_f32 v80, v80, v81
v_cvt_pk_bf16_f32 v81, v82, v83
v_cmp_ne_u32 vcc, 0, v9
ds_write_b64 v7, v[80:81] offset:256
s_mov_b64 exec, 1
s_cbranch_vccz L_nr_38
ds_write_b32 v15, v13 offset:36
L_nr_38:
ds_add_u32 v15, v13 offset:0
s_mov_b64 exec, -1
s_mov_b32 s31, 0xffff0000
s_mov_b32 s60, 1048576
L_qr_39:
ds_read_b32 v14, v15 offset:0
ds_read_b128 v[8:11], v109 offset:256
s_waitcnt lgkmcnt(1)
v_readfirstlane_b32 s61, v14
s_cmp_ge_u32 s61, 4
s_cbranch_scc1 L_qrd_40
s_sub_u32 s60, s60, 1
s_cbranch_scc0 L_qr_39
L_qrd_40:
s_waitcnt lgkmcnt(0)
v_mfma_f32_16x16x32_bf16 v[80:83], v[16:19], v[8:11], 0
v_mfma_f32_16x16x32_bf16 v[84:87], v[20:23], v[8:11], 0
v_mfma_f32_16x16x32_bf16 v[88:91], v[24:27], v[8:11], 0
v_mfma_f32_16x16x32_bf16 v[92:95], v[28:31], v[8:11], 0
s_nop 4
v_add_f32_dpp v112, v81, v80 row_ror:12 row_mask:0xf bank_mask:0x1
v_add_f32_dpp v112, v82, v112 row_ror:8 row_mask:0xf bank_mask:0x1
v_add_f32_dpp v112, v83, v112 row_ror:4 row_mask:0xf bank_mask:0x1
v_mfma_f32_16x16x32_bf16 v[96:99], v[32:35], v[8:11], 0
v_add_f32_dpp v113, v85, v84 row_ror:12 row_mask:0xf bank_mask:0x1
v_add_f32_dpp v113, v86, v113 row_ror:8 row_mask:0xf bank_mask:0x1
v_add_f32_dpp v113, v87, v113 row_ror:4 row_mask:0xf bank_mask:0x1
v_mfma_f32_16x16x32_bf16 v[100:103], v[36:39], v[8:11], 0
v_add_f32_dpp v114, v89, v88 row_ror:12 row_mask:0xf bank_mask:0x1
v_add_f32_dpp v114, v90, v114 row_ror:8 row_mask:0xf bank_mask:0x1
v_add_f32_dpp v114, v91, v114 row_ror:4 row_mask:0xf bank_mask:0x1
v_mfma_f32_16x16x32_bf16 v[104:107], v[40:43], v[8:11], 0
v_add_f32_dpp v115, v93, v92 row_ror:12 row_mask:0xf bank_mask:0x1
v_add_f32_dpp v115, v94, v115 row_ror:8 row_mask:0xf bank_mask:0x1
v_add_f32_dpp v115, v95, v115 row_ror:4 row_mask:0xf bank_mask:0x1
v_mfma_f32_16x16x32_bf16 v[108:111], v[44:47], v[8:11], 0
v_add_f32_dpp v112, v96, v97 row_ror:4 row_mask:0xf bank_mask:0x2
v_add_f32_dpp v112, v98, v112 row_ror:12 row_mask:0xf bank_mask:0x2
v_add_f32_dpp v112, v99, v112 row_ror:8 row_mask:0xf bank_mask:0x2
v_mfma_f32_16x16x32_bf16 v[80:83], v[48:51], v[8:11], 0
v_add_f32_dpp v113, v100, v101 row_ror:4 row_mask:0xf bank_mask:0x2
v_add_f32_dpp v113, v102, v113 row_ror:12 row_mask:0xf bank_mask:0x2
v_add_f32_dpp v113, v103, v113 row_ror:8 row_mask:0xf bank_mask:0x2
v_mfma_f32_16x16x32_bf16 v[84:87], v[52:55], v[8:11], 0
v_add_f32_dpp v114, v104, v105 row_ror:4 row_mask:0xf bank_mask:0x2
v_add_f32_dpp v114, v106, v114 row_ror:12 row_mask:0xf bank_mask:0x2
v_add_f32_dpp v114, v107, v114 row_ror:8 row_mask:0xf bank_mask:0x2
v_mfma_f32_16x16x32_bf16 v[88:91], v[56:59], v[8:11], 0
v_add_f32_dpp v115, v108, v109 row_ror:4 row_mask:0xf bank_mask:0x2
v_add_f32_dpp v115, v110, v115 row_ror:12 row_mask:0xf bank_mask:0x2
v_add_f32_dpp v115, v111, v115 row_ror:8 row_mask:0xf bank_mask:0x2
v_mfma_f32_16x16x32_bf16 v[92:95], v[60:63], v[8:11], 0
v_add_f32_dpp v112, v80, v82 row_ror:8 row_mask:0xf bank_mask:0x4
v_add_f32_dpp v112, v81, v112 row_ror:4 row_mask:0xf bank_mask:0x4
v_add_f32_dpp v112, v83, v112 row_ror:12 row_mask:0xf bank_mask:0x4
v_mfma_f32_16x16x32_bf16 v[96:99], v[64:67], v[8:11], 0
v_add_f32_dpp v113, v84, v86 row_ror:8 row_mask:0xf bank_mask:0x4
v_add_f32_dpp v113, v85, v113 row_ror:4 row_mask:0xf bank_mask:0x4
v_add_f32_dpp v113, v87, v113 row_ror:12 row_mask:0xf bank_mask:0x4
v_mfma_f32_16x16x32_bf16 v[100:103], v[68:71], v[8:11], 0
v_add_f32_dpp v114, v88, v90 row_ror:8 row_mask:0xf bank_mask:0x4
v_add_f32_dpp v114, v89, v114 row_ror:4 row_mask:0xf bank_mask:0x4
v_add_f32_dpp v114, v91, v114 row_ror:12 row_mask:0xf bank_mask:0x4
v_mfma_f32_16x16x32_bf16 v[104:107], v[72:75], v[8:11], 0
v_add_f32_dpp v115, v92, v94 row_ror:8 row_mask:0xf bank_mask:0x4
v_add_f32_dpp v115, v93, v115 row_ror:4 row_mask:0xf bank_mask:0x4
v_add_f32_dpp v115, v95, v115 row_ror:12 row_mask:0xf bank_mask:0x4
v_mfma_f32_16x16x32_bf16 v[108:111], v[76:79], v[8:11], 0
v_add_f32_dpp v112, v96, v99 row_ror:12 row_mask:0xf bank_mask:0x8
v_add_f32_dpp v112, v97, v112 row_ror:8 row_mask:0xf bank_mask:0x8
v_add_f32_dpp v112, v98, v112 row_ror:4 row_mask:0xf bank_mask:0x8
v_add_f32_dpp v113, v100, v103 row_ror:12 row_mask:0xf bank_mask:0x8
v_add_f32_dpp v113, v101, v113 row_ror:8 row_mask:0xf bank_mask:0x8
v_add_f32_dpp v113, v102, v113 row_ror:4 row_mask:0xf bank_mask:0x8
s_nop 0
v_add_f32_dpp v114, v104, v107 row_ror:12 row_mask:0xf bank_mask:0x8
v_add_f32_dpp v114, v105, v114 row_ror:8 row_mask:0xf bank_mask:0x8
v_add_f32_dpp v114, v106, v114 row_ror:4 row_mask:0xf bank_mask:0x8
v_add_f32_dpp v115, v108, v111 row_ror:12 row_mask:0xf bank_mask:0x8
v_add_f32_dpp v115, v109, v115 row_ror:8 row_mask:0xf bank_mask:0x8
v_add_f32_dpp v115, v110, v115 row_ror:4 row_mask:0xf bank_mask:0x8
v_cvt_pk_bf16_f32 v80, v112, v113
v_cvt_pk_bf16_f32 v81, v114, v115
v_lshlrev_b32 v112, 16, v80
v_and_b32 v113, s31, v80
v_lshlrev_b32 v114, 16, v81
v_and_b32 v115, s31, v81
v_mul_f32 v112, s28, v112
v_mul_f32 v113, s28, v113
v_mul_f32 v114, s28, v114
v_mul_f32 v115, s28, v115
v_cvt_pk_bf16_f32 v80, v112, v113
v_cvt_pk_bf16_f32 v81, v114, v115
v_lshlrev_b32 v112, 16, v80
v_and_b32 v113, s31, v80
v_lshlrev_b32 v114, 16, v81
v_and_b32 v115, s31, v81
v_max3_f32 v12, v112, v113, v114
v_max_f32 v12, v12, v115
s_nop 1
v_max_f32_dpp v12, v12, v12 row_ror:4 row_mask:0xf bank_mask:0xf
s_nop 1
v_max_f32_dpp v12, v12, v12 row_ror:8 row_mask:0xf bank_mask:0xf
v_mov_b32 v14, v12
s_nop 1
v_permlane16_swap_b32 v12, v14
s_nop 0
v_max_f32 v12, v12, v14
v_mov_b32 v14, v12
s_nop 1
v_permlane32_swap_b32 v12, v14
s_nop 0
v_max_f32 v12, v12, v14
v_mul_f32 v12, s29, v12
v_fma_f32 v112, v112, s29, -v12
v_fma_f32 v113, v113, s29, -v12
v_fma_f32 v114, v114, s29, -v12
v_fma_f32 v115, v115, s29, -v12
v_exp_f32 v112, v112
v_exp_f32 v113, v113
v_exp_f32 v114, v114
v_exp_f32 v115, v115
s_nop 0
v_cvt_pk_bf16_f32 v88, v112, v113
v_cvt_pk_bf16_f32 v89, v114, v115
ds_write_b64 v4, v[88:89] offset:2048
ds_write_b32 v1, v13 offset:64
v_add_f32 v7, v112, v113
v_add_f32 v14, v114, v115
v_add_f32 v7, v7, v14
s_nop 1
v_add_f32_dpp v7, v7, v7 row_ror:4 row_mask:0xf bank_mask:0xf
s_nop 1
v_add_f32_dpp v7, v7, v7 row_ror:8 row_mask:0xf bank_mask:0xf
v_mov_b32 v14, v7
s_nop 1
v_permlane16_swap_b32 v7, v14
s_nop 0
v_add_f32 v7, v7, v14
v_mov_b32 v14, v7
s_nop 1
v_permlane32_swap_b32 v7, v14
s_nop 0
v_add_f32 v7, v7, v14
s_lshl_b32 s30, s26, 2
v_lshl_add_u32 v6, v5, 4, s30
s_mov_b64 exec, 15
ds_write_b32 v6, v12 offset:1280
ds_write_b32 v6, v7 offset:1344
s_mov_b64 exec, 1
ds_add_u32 v15, v13 offset:4
s_mov_b64 exec, -1
s_add_u32 s45, s46, s21
s_mul_i32 s45, s45, 4352
s_mul_i32 s30, s26, 640
s_add_u32 s45, s45, s30
s_lshl_b32 s30, s26, 9
v_lshl_add_u32 v8, v2, 3, s30
v_bfe_u32 v5, v2, 1, 2
v_lshlrev_b32 v5, 4, v5
v_lshrrev_b32 v4, 3, v2
v_mul_u32_u24 v4, 80, v4
v_lshrrev_b32 v6, 2, v5
v_add_u32 v6, v6, v4
v_and_b32 v7, 7, v2
v_lshl_add_u32 v4, v7, 3, v4
s_mov_b32 s60, 1048576
L_lw_41:
ds_read_b32 v14, v15 offset:4
s_waitcnt lgkmcnt(0)
v_readfirstlane_b32 s61, v14
s_cmp_ge_u32 s61, 4
s_cbranch_scc1 L_lwd_42
s_sub_u32 s60, s60, 1
s_cbranch_scc0 L_lw_41
L_lwd_42:
ds_read_b128 v[80:83], v5 offset:1280
ds_read_b128 v[84:87], v5 offset:1344
ds_read_b32 v9, v15 offset:36
s_waitcnt lgkmcnt(0)
v_readfirstlane_b32 s33, v9
v_max3_f32 v14, v80, v81, v82
v_max_f32 v14, v14, v83
v_sub_f32 v80, v80, v14
v_sub_f32 v81, v81, v14
v_sub_f32 v82, v82, v14
v_sub_f32 v83, v83, v14
v_exp_f32 v80, v80
v_exp_f32 v81, v81
v_exp_f32 v82, v82
v_exp_f32 v83, v83
v_mul_f32 v7, v80, v84
v_fmac_f32 v7, v81, v85
v_fmac_f32 v7, v82, v86
v_fmac_f32 v7, v83, v87
v_log_f32 v24, v7
v_rcp_f32 v7, v7
v_add_f32 v24, v24, v14
v_mul_f32 v80, v80, v7
v_mul_f32 v81, v81, v7
v_mul_f32 v82, v82, v7
v_mul_f32 v83, v83, v7
s_cmp_lg_u32 s33, 0
s_cbranch_scc1 L_opr_43
buffer_store_dword v24, v6, s[40:43], s45 offen offset:1600
s_branch L_opd_44
L_opr_43:
buffer_store_dword v24, v6, s[40:43], s45 offen offset:1600 sc1
L_opd_44:
s_mov_b32 s60, 1048576
L_lw_45:
ds_read_b32 v14, v15 offset:12
s_waitcnt lgkmcnt(0)
v_readfirstlane_b32 s61, v14
s_cmp_ge_u32 s61, 1
s_cbranch_scc1 L_lwd_46
s_sleep 1
s_sub_u32 s60, s60, 1
s_cbranch_scc0 L_lw_45
L_lwd_46:
s_mov_b32 s60, 1048576
L_ow_47:
ds_read_b32 v14, v15 offset:12
ds_read2st64_b64 v[16:19], v8 offset0:20 offset1:24
ds_read2st64_b64 v[20:23], v8 offset0:28 offset1:32
s_waitcnt lgkmcnt(2)
v_readfirstlane_b32 s61, v14
s_cmp_ge_u32 s61, 4
s_cbranch_scc1 L_owd_48
s_sub_u32 s60, s60, 1
s_cbranch_scc0 L_ow_47
L_owd_48:
s_waitcnt lgkmcnt(1)
v_mul_f32 v96, v16, v80
v_mul_f32 v97, v17, v80
v_fmac_f32 v96, v18, v81
v_fmac_f32 v97, v19, v81
s_waitcnt lgkmcnt(0)
v_fmac_f32 v96, v20, v82
v_fmac_f32 v97, v21, v82
v_fmac_f32 v96, v22, v83
v_fmac_f32 v97, v23, v83
s_cmp_lg_u32 s33, 0
s_cbranch_scc1 L_opr_49
buffer_store_dwordx2 v[96:97], v4, s[40:43], s45 offen offset:1536
s_branch L_opd_50
L_opr_49:
buffer_store_dwordx2 v[96:97], v4, s[40:43], s45 offen offset:1536 sc1
L_opd_50:
L_end:
s_endpgm
.section .rodata,"a"
.p2align 6
.amdhsa_kernel standalone__sliding_block_cached__decode_kernel
  .amdhsa_next_free_vgpr 168
  .amdhsa_next_free_sgpr 100
  .amdhsa_accum_offset 168
  .amdhsa_group_segment_fixed_size 0
  .amdhsa_kernarg_size 64
  .amdhsa_user_sgpr_count 2
  .amdhsa_user_sgpr_kernarg_segment_ptr 1
  .amdhsa_system_sgpr_workgroup_id_x 1
.end_amdhsa_kernel
```
